```python
import torch

def _softmax(x, axis=-1):
    return torch.softmax(x, dim=axis)

def _gelu(x):
    return torch.nn.functional.gelu(x, approximate='tanh')

def _silu(x):
    return torch.nn.functional.silu(x)

def _sigmoid(x):
    return torch.sigmoid(x)

def _layernorm(x, axis=-1, eps=1e-05):
    m = x.mean(dim=axis, keepdim=True)
    v = x.var(dim=axis, keepdim=True, unbiased=False)
    return (x - m) / torch.sqrt(v + eps)

def _scatter_add(tgt, idx, src, axis=0):
    return tgt.clone().index_add_(axis, idx, src)

def _segment_sum(src, seg, n):
    out = torch.zeros((n,) + src.shape[1:], dtype=src.dtype)
    return out.index_add_(0, seg, src)

def _pad(x, pw):
    flat = tuple((v for pair in reversed(pw) for v in pair))
    return torch.nn.functional.pad(x, flat)
kernel_name = 'standalone__kv_cache_quant_pre_rope_vs_post_rope__decode'

def setup_inputs():

    _w = lambda a: (lambda t: t.to(torch.bfloat16) if t.is_floating_point() else t)(torch.as_tensor(a))
    B, Sq, Skv = (4, 1, 8192)
    H, Dh0 = (4, 128)
    G = 64 if 64 > 0 else Dh0
    G = max(2, G // 2 * 2)
    Dh = max(G, Dh0 // G * G)
    Skv = max(Skv, Sq)
    ng = Dh // G
    bits = 2 if 2 > 1 else 4
    bits = max(2, min(8, bits))
    qmax = (1 << bits) - 1
    half = Dh // 2
    inv = 1.0 / 10000.0 ** (torch.arange(half) / max(1, half))
    ang_k = torch.arange(Skv)[:, None] * inv[None, :]
    ang_q = torch.arange(Skv - Sq, Skv)[:, None] * inv[None, :]
    kc = torch.cat([torch.cos(ang_k), torch.cos(ang_k)], dim=-1)
    ks = torch.cat([torch.sin(ang_k), torch.sin(ang_k)], dim=-1)
    qc = torch.cat([torch.cos(ang_q), torch.cos(ang_q)], dim=-1)
    qs = torch.cat([torch.sin(ang_q), torch.sin(ang_q)], dim=-1)
    qk_i = torch.randint(0, qmax + 1, (B, H, Skv, Dh)).to(torch.int32)
    qv_i = torch.randint(0, qmax + 1, (B, H, Skv, Dh)).to(torch.int32)
    ksc = torch.abs((lambda *s: torch.randn(*s, dtype=torch.bfloat16) * 0.4)(B, H, Skv, ng)) * 0.1 + 0.01
    kzp = torch.full((B, H, Skv, ng), qmax / 2.0)
    vsc = torch.abs((lambda *s: torch.randn(*s, dtype=torch.bfloat16) * 0.4)(B, H, Skv, ng)) * 0.1 + 0.01
    vzp = torch.full((B, H, Skv, ng), qmax / 2.0)
    return {'q': _w((lambda *s: torch.randn(*s, dtype=torch.bfloat16) * 12.8)(B, H, Sq, Dh) * 0.5), 'qk': _w(qk_i), 'k_scales': _w(ksc), 'k_zeros': _w(kzp), 'qv': _w(qv_i), 'v_scales': _w(vsc), 'v_zeros': _w(vzp), 'q_cos': _w(qc), 'q_sin': _w(qs), 'k_cos': _w(kc), 'k_sin': _w(ks)}

def reference(q, qk, k_scales, k_zeros, qv, v_scales, v_zeros, q_cos, q_sin, k_cos, k_sin):
    B, H, Sq, Dh = q.shape
    ng = k_scales.shape[-1]
    G = Dh // ng
    half = Dh // 2
    ks = (lambda x, n, axis: torch.repeat_interleave(x, n, dim=axis))(k_scales, G, axis=-1)
    kz = (lambda x, n, axis: torch.repeat_interleave(x, n, dim=axis))(k_zeros, G, axis=-1)
    k = ((lambda x, dt: x.to(dt))(qk, q.dtype) - kz) * ks
    vs = (lambda x, n, axis: torch.repeat_interleave(x, n, dim=axis))(v_scales, G, axis=-1)
    vz = (lambda x, n, axis: torch.repeat_interleave(x, n, dim=axis))(v_zeros, G, axis=-1)
    v = ((lambda x, dt: x.to(dt))(qv, q.dtype) - vz) * vs
    k1 = k[..., :half].clone()
    k2 = k[..., half:].clone()
    krh = torch.concatenate([-k2, k1], axis=-1)
    kr = k * k_cos[None, None, :, :] + krh * k_sin[None, None, :, :]
    q1 = q[..., :half].clone()
    q2 = q[..., half:].clone()
    qrh = torch.concatenate([-q2, q1], axis=-1)
    qr = q * q_cos[None, None, :, :] + qrh * q_sin[None, None, :, :]
    logits = torch.einsum('bhqd,bhkd->bhqk', qr, kr) * float(Dh) ** (-0.5)
    attn = _softmax(logits, axis=-1)
    out = torch.einsum('bhqk,bhkd->bhqd', attn, v)
    return out
```

```asm
; @launch grid=(256,1,1) block=(256,1,1) lds=90112
.amdgcn_target "amdgcn-amd-amdhsa--gfx950"
.text
.globl standalone__kv_cache_quant_pre_rope_vs_post_rope__decode_kernel
.p2align 8
.type standalone__kv_cache_quant_pre_rope_vs_post_rope__decode_kernel,@function
standalone__kv_cache_quant_pre_rope_vs_post_rope__decode_kernel:
    s_cmp_ge_u32 s2, 256
    s_cbranch_scc1 L_end
    s_load_dwordx16 s[16:31], s[0:1], 0
    s_load_dwordx8 s[32:39], s[0:1], 64
    s_load_dwordx4 s[40:43], s[0:1], 96
    v_lshrrev_b32 v1, 6, v0
    v_and_b32 v0, 63, v0
    v_readfirstlane_b32 s3, v1
    v_lshlrev_b32 v1, 4, v0
    s_and_b32 s12, s2, 7
    s_lshl_b32 s12, s12, 5
    s_lshr_b32 s13, s2, 3
    s_add_u32 s15, s12, s13
    s_lshr_b32 s11, s15, 4
    s_lshl_b32 s4, s15, 18
    s_lshl_b32 s12, s3, 10
    s_add_u32 s4, s4, s12
    s_mov_b32 s96, s4
    s_lshr_b32 s7, s2, 3
    s_add_u32 s7, s7, s2
    s_and_b32 s7, s7, 3
    s_lshl_b32 s12, s7, 16
    s_add_u32 s4, s4, s12
    s_mov_b32 s46, 0x4000000
    s_mov_b32 s47, 0x00020000
    s_mov_b32 s50, 0x4000000
    s_mov_b32 s51, 0x00020000
    s_and_b32 s13, s15, 15
    s_lshl_b32 s13, s13, 9
    s_lshl_b32 s14, s3, 1
    s_lshl_b32 s10, s11, 8
    s_getpc_b64 s[8:9]
L_pc:
    s_add_u32 s8, s8, rope_consts-L_pc
    s_addc_u32 s9, s9, 0
    s_waitcnt lgkmcnt(0)
    s_mov_b64 s[44:45], s[18:19]
    s_mov_b64 s[48:49], s[24:25]
    buffer_load_dwordx4 v[80:83], v1, s[44:47], s4 offen nt
    s_add_u32 s12, s4, 4096
    buffer_load_dwordx4 v[84:87], v1, s[44:47], s12 offen nt
    s_add_u32 s12, s4, 8192
    buffer_load_dwordx4 v[88:91], v1, s[44:47], s12 offen nt
    s_cmp_eq_u32 s3, 0
    s_cselect_b32 s92, s22, s20
    s_cselect_b32 s93, s23, s21
    s_cmp_eq_u32 s3, 2
    s_cselect_b32 s92, s26, s92
    s_cselect_b32 s93, s27, s93
    s_cmp_eq_u32 s3, 3
    s_cselect_b32 s92, s28, s92
    s_cselect_b32 s93, s29, s93
    s_mov_b32 s94, 0x80000
    s_mov_b32 s95, 0x00020000
    s_lshl_b32 s12, s3, 11
    s_mov_b32 m0, s12
    s_lshl_b32 s12, s15, 11
    buffer_load_dwordx4 v1, s[92:95], s12 offen lds
    buffer_load_dwordx4 v1, s[92:95], s12 offen offset:1024 lds
    s_mov_b64 s[68:69], s[16:17]
    s_mov_b32 s70, 0x1000
    s_mov_b32 s71, 0x00020000
    s_mov_b64 s[72:73], s[30:31]
    s_mov_b32 s74, 0x100
    s_mov_b32 s75, 0x00020000
    s_mov_b64 s[76:77], s[32:33]
    s_mov_b32 s78, 0x100
    s_mov_b32 s79, 0x00020000
    s_lshl_b32 s12, s3, 6
    v_add_u32 v33, s12, v0
    v_lshlrev_b32 v34, 1, v33
    v_xor_b32 v35, 0x80, v34
    s_cmp_ge_u32 s3, 2
    s_cbranch_scc1 L_noqld
    buffer_load_ushort v24, v34, s[68:71], s10 offen
    buffer_load_ushort v25, v35, s[68:71], s10 offen
    buffer_load_ushort v26, v34, s[72:75], 0 offen
    buffer_load_ushort v27, v34, s[76:79], 0 offen
L_noqld:
    s_cmp_lg_u32 s3, 2
    s_cbranch_scc1 L_nocld
    global_load_dwordx4 v[44:47], v1, s[8:9]
L_nocld:
    s_add_u32 s12, s4, 12288
    buffer_load_dwordx4 v[92:95], v1, s[44:47], s12 offen nt
    s_add_u32 s12, s4, 16384
    buffer_load_dwordx4 v[96:99], v1, s[44:47], s12 offen nt
    s_add_u32 s12, s4, 20480
    buffer_load_dwordx4 v[100:103], v1, s[44:47], s12 offen nt
    s_add_u32 s12, s4, 24576
    buffer_load_dwordx4 v[104:107], v1, s[44:47], s12 offen nt
    s_add_u32 s12, s4, 28672
    buffer_load_dwordx4 v[108:111], v1, s[44:47], s12 offen nt
    s_add_u32 s12, s4, 32768
    buffer_load_dwordx4 v[112:115], v1, s[44:47], s12 offen nt
    s_add_u32 s12, s4, 36864
    buffer_load_dwordx4 v[116:119], v1, s[44:47], s12 offen nt
    s_add_u32 s12, s4, 40960
    buffer_load_dwordx4 v[120:123], v1, s[44:47], s12 offen nt
    s_add_u32 s12, s4, 45056
    buffer_load_dwordx4 v[124:127], v1, s[44:47], s12 offen nt
    s_add_u32 s12, s4, 49152
    buffer_load_dwordx4 v[128:131], v1, s[44:47], s12 offen nt
    s_add_u32 s12, s4, 53248
    buffer_load_dwordx4 v[132:135], v1, s[44:47], s12 offen nt
    s_add_u32 s12, s4, 57344
    buffer_load_dwordx4 v[136:139], v1, s[44:47], s12 offen nt
    s_add_u32 s12, s4, 61440
    buffer_load_dwordx4 v[140:143], v1, s[44:47], s12 offen nt
    s_waitcnt vmcnt(13)
    v_lshlrev_b32 v24, 16, v24
    v_lshlrev_b32 v25, 16, v25
    v_lshlrev_b32 v26, 16, v26
    v_lshlrev_b32 v27, 16, v27
    s_cmp_eq_u32 s3, 0
    s_cselect_b32 s12, 0x80000000, 0
    v_mul_f32 v36, v24, v26
    v_xor_b32 v25, s12, v25
    v_mul_f32 v37, v25, v27
    v_cvt_pk_bf16_f32 v36, v36, v37
    v_lshlrev_b32 v37, 16, v36
    v_and_b32 v36, 0xffff0000, v36
    v_add_f32 v36, v36, v37
    v_cvt_pk_bf16_f32 v36, v36, v36
    v_lshlrev_b32 v36, 16, v36
    v_lshlrev_b32 v33, 2, v33
    s_cmp_ge_u32 s3, 2
    s_cbranch_scc1 L_noq
    ds_write_b32 v33, v36 offset:8192
L_noq:
    s_cmp_lg_u32 s3, 2
    s_cbranch_scc1 L_noc
    ds_write_b128 v1, v[44:47] offset:8704
L_noc:
    s_waitcnt lgkmcnt(0)
    s_barrier
    s_mov_b64 s[80:81], s[38:39]
    s_mov_b32 s82, 0x1000
    s_mov_b32 s83, 0x00020000
    s_mov_b64 s[84:85], s[42:43]
    s_mov_b32 s86, 0x200000
    s_mov_b32 s87, 0x00020000
    s_mov_b64 s[88:89], s[40:41]
    s_mov_b32 s90, 0x100
    s_mov_b32 s91, 0x00020000
    s_mov_b32 s16, 0xcccccccc
    s_mov_b32 s17, 0xcccccccc
    s_mov_b32 s18, 0xaaaaaaaa
    s_mov_b32 s19, 0xaaaaaaaa
    s_mov_b32 s22, 0x3e0293ee
    s_mov_b32 s23, 0x7c000000
    v_and_b32 v33, 31, v0
    v_lshlrev_b32 v33, 4, v33
    v_xor_b32 v34, 0x100, v33
    v_and_b32 v35, 15, v0
    v_lshlrev_b32 v36, 4, v35
    ds_read_b128 v[60:63], v33 offset:8192
    ds_read_b128 v[64:67], v34 offset:8192
    ds_read_b128 v[44:47], v36 offset:8704
    ds_read_b128 v[48:51], v36 offset:8960
    ds_read_b128 v[16:19], v36 offset:9216
    ds_read_b128 v[52:55], v36 offset:9472
    v_lshlrev_b32 v35, 5, v35
    v_lshrrev_b32 v37, 4, v0
    v_lshl_add_u32 v35, v37, 1, v35
    s_lshl_b32 s12, s14, 2
    v_add_u32 v69, s12, v35
    s_lshl_b32 s12, s7, 9
    v_add_u32 v2, s12, v69
    ds_read_u16 v42, v2 offset:0
    v_and_b32 v37, 16, v0
    v_lshlrev_b32 v38, 27, v37
    v_lshrrev_b32 v68, 5, v0
    s_add_u32 s12, s13, s14
    v_add_u32 v68, s12, v68
    s_waitcnt lgkmcnt(0)
    v_xor_b32 v64, v38, v64
    v_xor_b32 v65, v38, v65
    v_xor_b32 v66, v38, v66
    v_xor_b32 v67, v38, v67
    v_mov_b32 v40, 0xff800000
    v_mov_b32 v41, 0
    v_mov_b32 v20, 0
    v_mov_b32 v21, 0
    v_mov_b32 v22, 0
    v_mov_b32 v23, 0
    s_mov_b32 s6, 0
L_chunke:
    s_add_u32 s14, s7, 1
    s_and_b32 s14, s14, 3
    s_lshl_b32 s5, s14, 16
    s_add_u32 s5, s5, s96
    s_cmp_eq_u32 s6, 3
    s_cselect_b32 s5, s23, s5
    s_waitcnt lgkmcnt(0)
    v_lshlrev_b32 v3, 16, v42
    ds_read_u16 v4, v2 offset:2048
    ds_read_u16 v5, v2 offset:4096
    ds_read_u16 v6, v2 offset:6144
    s_lshl_b32 s12, s14, 9
    v_add_u32 v2, s12, v69
    ds_read_u16 v42, v2 offset:0
    s_lshl_b32 s12, s7, 7
    v_add_u32 v39, s12, v68
    v_cvt_f32_u32 v39, v39
    s_mov_b32 s7, s14
    v_mul_f32 v72, v39, v44
    v_mul_f32 v73, v39, v45
    v_mul_f32 v74, v39, v46
    v_mul_f32 v75, v39, v47
    v_fract_f32 v72, v72
    v_fract_f32 v73, v73
    v_fract_f32 v74, v74
    v_fract_f32 v75, v75
    v_fmac_f32 v72, v39, v48
    v_fmac_f32 v73, v39, v49
    v_fmac_f32 v74, v39, v50
    v_fmac_f32 v75, v39, v51
    v_sin_f32 v76, v72
    v_sin_f32 v77, v73
    v_sin_f32 v78, v74
    v_sin_f32 v79, v75
    v_cos_f32 v72, v72
    v_cos_f32 v73, v73
    v_cos_f32 v74, v74
    v_cos_f32 v75, v75
    s_nop 0
    v_mul_f32 v8, v60, v72
    v_mul_f32 v9, v61, v73
    v_mul_f32 v10, v62, v74
    v_mul_f32 v11, v63, v75
    v_fmac_f32 v8, v64, v76
    v_fmac_f32 v9, v65, v77
    v_fmac_f32 v10, v66, v78
    v_fmac_f32 v11, v67, v79
    v_mul_f32 v24, v64, v72
    v_mul_f32 v25, v65, v73
    v_mul_f32 v26, v66, v74
    v_mul_f32 v27, v67, v75
    v_fma_f32 v24, -v60, v76, v24
    v_fma_f32 v25, -v61, v77, v25
    v_fma_f32 v26, -v62, v78, v26
    v_fma_f32 v27, -v63, v79, v27
    v_mul_f32 v12, v16, v8
    v_mul_f32 v13, v17, v9
    v_mul_f32 v14, v18, v10
    v_mul_f32 v15, v19, v11
    v_mul_f32 v24, v52, v24
    v_mul_f32 v25, v53, v25
    v_mul_f32 v26, v54, v26
    v_mul_f32 v27, v55, v27
    v_fma_f32 v12, v12, 0.5, -v24
    v_fma_f32 v13, v13, 0.5, -v25
    v_fma_f32 v14, v14, 0.5, -v26
    v_fma_f32 v15, v15, 0.5, -v27
    v_mov_b32_dpp v7, v3 row_newbcast:0 row_mask:0xf bank_mask:0xf
    s_waitcnt vmcnt(14)
    s_cmp_eq_u32 s6, 0
    s_cbranch_scc1 L_skipe_15
    s_add_u32 s12, s4, 61440
    buffer_load_dwordx4 v[140:143], v1, s[44:47], s12 offen nt
L_skipe_15:
    v_cvt_f32_i32 v80, v80
    v_cvt_f32_i32 v81, v81
    v_cvt_f32_i32 v82, v82
    v_cvt_f32_i32 v83, v83
    v_sub_f32 v80, v80, v7
    v_sub_f32 v81, v81, v7
    v_sub_f32 v82, v82, v7
    v_sub_f32 v83, v83, v7
    v_mul_f32 v24, v80, v8
    v_fmac_f32 v24, v81, v9
    v_fmac_f32 v24, v82, v10
    v_fmac_f32 v24, v83, v11
    v_fma_f32 v12, v16, v8, -v12
    v_fma_f32 v13, v17, v9, -v13
    v_fma_f32 v14, v18, v10, -v14
    v_fma_f32 v15, v19, v11, -v15
    v_mov_b32_dpp v7, v3 row_newbcast:1 row_mask:0xf bank_mask:0xf
    s_waitcnt vmcnt(14)
    buffer_load_dwordx4 v[80:83], v1, s[48:51], s4 offen nt
    v_cvt_f32_i32 v84, v84
    v_cvt_f32_i32 v85, v85
    v_cvt_f32_i32 v86, v86
    v_cvt_f32_i32 v87, v87
    v_sub_f32 v84, v84, v7
    v_sub_f32 v85, v85, v7
    v_sub_f32 v86, v86, v7
    v_sub_f32 v87, v87, v7
    v_mul_f32 v25, v84, v12
    v_fmac_f32 v25, v85, v13
    v_fmac_f32 v25, v86, v14
    v_fmac_f32 v25, v87, v15
    v_fma_f32 v8, v16, v12, -v8
    v_fma_f32 v9, v17, v13, -v9
    v_fma_f32 v10, v18, v14, -v10
    v_fma_f32 v11, v19, v15, -v11
    v_mov_b32_dpp v7, v3 row_newbcast:2 row_mask:0xf bank_mask:0xf
    s_waitcnt vmcnt(14)
    s_add_u32 s12, s4, 4096
    buffer_load_dwordx4 v[84:87], v1, s[48:51], s12 offen nt
    v_cvt_f32_i32 v88, v88
    v_cvt_f32_i32 v89, v89
    v_cvt_f32_i32 v90, v90
    v_cvt_f32_i32 v91, v91
    v_sub_f32 v88, v88, v7
    v_sub_f32 v89, v89, v7
    v_sub_f32 v90, v90, v7
    v_sub_f32 v91, v91, v7
    v_mul_f32 v26, v88, v8
    v_fmac_f32 v26, v89, v9
    v_fmac_f32 v26, v90, v10
    v_fmac_f32 v26, v91, v11
    v_fma_f32 v12, v16, v8, -v12
    v_fma_f32 v13, v17, v9, -v13
    v_fma_f32 v14, v18, v10, -v14
    v_fma_f32 v15, v19, v11, -v15
    v_mov_b32_dpp v7, v3 row_newbcast:3 row_mask:0xf bank_mask:0xf
    s_waitcnt vmcnt(14)
    s_add_u32 s12, s4, 8192
    buffer_load_dwordx4 v[88:91], v1, s[48:51], s12 offen nt
    v_cvt_f32_i32 v92, v92
    v_cvt_f32_i32 v93, v93
    v_cvt_f32_i32 v94, v94
    v_cvt_f32_i32 v95, v95
    v_sub_f32 v92, v92, v7
    v_sub_f32 v93, v93, v7
    v_sub_f32 v94, v94, v7
    v_sub_f32 v95, v95, v7
    v_mul_f32 v27, v92, v12
    v_fmac_f32 v27, v93, v13
    v_fmac_f32 v27, v94, v14
    v_fmac_f32 v27, v95, v15
    v_fma_f32 v8, v16, v12, -v8
    v_fma_f32 v9, v17, v13, -v9
    v_fma_f32 v10, v18, v14, -v10
    v_fma_f32 v11, v19, v15, -v11
    v_mov_b32_dpp v7, v3 row_newbcast:4 row_mask:0xf bank_mask:0xf
    s_waitcnt vmcnt(14)
    s_add_u32 s12, s4, 12288
    buffer_load_dwordx4 v[92:95], v1, s[48:51], s12 offen nt
    v_cvt_f32_i32 v96, v96
    v_cvt_f32_i32 v97, v97
    v_cvt_f32_i32 v98, v98
    v_cvt_f32_i32 v99, v99
    v_sub_f32 v96, v96, v7
    v_sub_f32 v97, v97, v7
    v_sub_f32 v98, v98, v7
    v_sub_f32 v99, v99, v7
    v_mul_f32 v28, v96, v8
    v_fmac_f32 v28, v97, v9
    v_fmac_f32 v28, v98, v10
    v_fmac_f32 v28, v99, v11
    v_fma_f32 v12, v16, v8, -v12
    v_fma_f32 v13, v17, v9, -v13
    v_fma_f32 v14, v18, v10, -v14
    v_fma_f32 v15, v19, v11, -v15
    v_mov_b32_dpp v7, v3 row_newbcast:5 row_mask:0xf bank_mask:0xf
    s_waitcnt vmcnt(14)
    s_add_u32 s12, s4, 16384
    buffer_load_dwordx4 v[96:99], v1, s[48:51], s12 offen nt
    v_cvt_f32_i32 v100, v100
    v_cvt_f32_i32 v101, v101
    v_cvt_f32_i32 v102, v102
    v_cvt_f32_i32 v103, v103
    v_sub_f32 v100, v100, v7
    v_sub_f32 v101, v101, v7
    v_sub_f32 v102, v102, v7
    v_sub_f32 v103, v103, v7
    v_mul_f32 v29, v100, v12
    v_fmac_f32 v29, v101, v13
    v_fmac_f32 v29, v102, v14
    v_fmac_f32 v29, v103, v15
    v_fma_f32 v8, v16, v12, -v8
    v_fma_f32 v9, v17, v13, -v9
    v_fma_f32 v10, v18, v14, -v10
    v_fma_f32 v11, v19, v15, -v11
    v_mov_b32_dpp v7, v3 row_newbcast:6 row_mask:0xf bank_mask:0xf
    s_waitcnt vmcnt(14)
    s_add_u32 s12, s4, 20480
    buffer_load_dwordx4 v[100:103], v1, s[48:51], s12 offen nt
    v_cvt_f32_i32 v104, v104
    v_cvt_f32_i32 v105, v105
    v_cvt_f32_i32 v106, v106
    v_cvt_f32_i32 v107, v107
    v_sub_f32 v104, v104, v7
    v_sub_f32 v105, v105, v7
    v_sub_f32 v106, v106, v7
    v_sub_f32 v107, v107, v7
    v_mul_f32 v30, v104, v8
    v_fmac_f32 v30, v105, v9
    v_fmac_f32 v30, v106, v10
    v_fmac_f32 v30, v107, v11
    v_fma_f32 v12, v16, v8, -v12
    v_fma_f32 v13, v17, v9, -v13
    v_fma_f32 v14, v18, v10, -v14
    v_fma_f32 v15, v19, v11, -v15
    v_mov_b32_dpp v7, v3 row_newbcast:7 row_mask:0xf bank_mask:0xf
    s_waitcnt vmcnt(14)
    s_add_u32 s12, s4, 24576
    buffer_load_dwordx4 v[104:107], v1, s[48:51], s12 offen nt
    v_cvt_f32_i32 v108, v108
    v_cvt_f32_i32 v109, v109
    v_cvt_f32_i32 v110, v110
    v_cvt_f32_i32 v111, v111
    v_sub_f32 v108, v108, v7
    v_sub_f32 v109, v109, v7
    v_sub_f32 v110, v110, v7
    v_sub_f32 v111, v111, v7
    v_mul_f32 v31, v108, v12
    v_fmac_f32 v31, v109, v13
    v_fmac_f32 v31, v110, v14
    v_fmac_f32 v31, v111, v15
    v_fma_f32 v8, v16, v12, -v8
    v_fma_f32 v9, v17, v13, -v9
    v_fma_f32 v10, v18, v14, -v10
    v_fma_f32 v11, v19, v15, -v11
    v_mov_b32_dpp v7, v3 row_newbcast:8 row_mask:0xf bank_mask:0xf
    v_add_f32_dpp v24, v24, v24 row_mirror row_mask:0xf bank_mask:0x3
    s_waitcnt vmcnt(14)
    s_add_u32 s12, s4, 28672
    buffer_load_dwordx4 v[108:111], v1, s[48:51], s12 offen nt
    v_cvt_f32_i32 v112, v112
    v_cvt_f32_i32 v113, v113
    v_cvt_f32_i32 v114, v114
    v_cvt_f32_i32 v115, v115
    v_sub_f32 v112, v112, v7
    v_sub_f32 v113, v113, v7
    v_sub_f32 v114, v114, v7
    v_sub_f32 v115, v115, v7
    v_mul_f32 v32, v112, v8
    v_fmac_f32 v32, v113, v9
    v_fmac_f32 v32, v114, v10
    v_fmac_f32 v32, v115, v11
    v_fma_f32 v12, v16, v8, -v12
    v_fma_f32 v13, v17, v9, -v13
    v_fma_f32 v14, v18, v10, -v14
    v_fma_f32 v15, v19, v11, -v15
    v_add_f32_dpp v24, v32, v32 row_mirror row_mask:0xf bank_mask:0xc
    v_mov_b32_dpp v7, v3 row_newbcast:9 row_mask:0xf bank_mask:0xf
    v_add_f32_dpp v25, v25, v25 row_mirror row_mask:0xf bank_mask:0x3
    s_waitcnt vmcnt(14)
    s_add_u32 s12, s4, 32768
    buffer_load_dwordx4 v[112:115], v1, s[48:51], s12 offen nt
    v_cvt_f32_i32 v116, v116
    v_cvt_f32_i32 v117, v117
    v_cvt_f32_i32 v118, v118
    v_cvt_f32_i32 v119, v119
    v_sub_f32 v116, v116, v7
    v_sub_f32 v117, v117, v7
    v_sub_f32 v118, v118, v7
    v_sub_f32 v119, v119, v7
    v_mul_f32 v32, v116, v12
    v_fmac_f32 v32, v117, v13
    v_fmac_f32 v32, v118, v14
    v_fmac_f32 v32, v119, v15
    v_fma_f32 v8, v16, v12, -v8
    v_fma_f32 v9, v17, v13, -v9
    v_fma_f32 v10, v18, v14, -v10
    v_fma_f32 v11, v19, v15, -v11
    v_add_f32_dpp v25, v32, v32 row_mirror row_mask:0xf bank_mask:0xc
    v_mov_b32_dpp v7, v3 row_newbcast:10 row_mask:0xf bank_mask:0xf
    v_add_f32_dpp v26, v26, v26 row_mirror row_mask:0xf bank_mask:0x3
    s_waitcnt vmcnt(14)
    s_add_u32 s12, s4, 36864
    buffer_load_dwordx4 v[116:119], v1, s[48:51], s12 offen nt
    v_cvt_f32_i32 v120, v120
    v_cvt_f32_i32 v121, v121
    v_cvt_f32_i32 v122, v122
    v_cvt_f32_i32 v123, v123
    v_sub_f32 v120, v120, v7
    v_sub_f32 v121, v121, v7
    v_sub_f32 v122, v122, v7
    v_sub_f32 v123, v123, v7
    v_mul_f32 v32, v120, v8
    v_fmac_f32 v32, v121, v9
    v_fmac_f32 v32, v122, v10
    v_fmac_f32 v32, v123, v11
    v_fma_f32 v12, v16, v8, -v12
    v_fma_f32 v13, v17, v9, -v13
    v_fma_f32 v14, v18, v10, -v14
    v_fma_f32 v15, v19, v11, -v15
    v_add_f32_dpp v26, v32, v32 row_mirror row_mask:0xf bank_mask:0xc
    v_mov_b32_dpp v7, v3 row_newbcast:11 row_mask:0xf bank_mask:0xf
    v_add_f32_dpp v27, v27, v27 row_mirror row_mask:0xf bank_mask:0x3
    s_waitcnt vmcnt(14)
    s_add_u32 s12, s4, 40960
    buffer_load_dwordx4 v[120:123], v1, s[48:51], s12 offen nt
    v_cvt_f32_i32 v124, v124
    v_cvt_f32_i32 v125, v125
    v_cvt_f32_i32 v126, v126
    v_cvt_f32_i32 v127, v127
    v_sub_f32 v124, v124, v7
    v_sub_f32 v125, v125, v7
    v_sub_f32 v126, v126, v7
    v_sub_f32 v127, v127, v7
    v_mul_f32 v32, v124, v12
    v_fmac_f32 v32, v125, v13
    v_fmac_f32 v32, v126, v14
    v_fmac_f32 v32, v127, v15
    v_fma_f32 v8, v16, v12, -v8
    v_fma_f32 v9, v17, v13, -v9
    v_fma_f32 v10, v18, v14, -v10
    v_fma_f32 v11, v19, v15, -v11
    v_add_f32_dpp v27, v32, v32 row_mirror row_mask:0xf bank_mask:0xc
    v_mov_b32_dpp v7, v3 row_newbcast:12 row_mask:0xf bank_mask:0xf
    v_add_f32_dpp v28, v28, v28 row_mirror row_mask:0xf bank_mask:0x3
    s_waitcnt vmcnt(14)
    s_add_u32 s12, s4, 45056
    buffer_load_dwordx4 v[124:127], v1, s[48:51], s12 offen nt
    v_cvt_f32_i32 v128, v128
    v_cvt_f32_i32 v129, v129
    v_cvt_f32_i32 v130, v130
    v_cvt_f32_i32 v131, v131
    v_sub_f32 v128, v128, v7
    v_sub_f32 v129, v129, v7
    v_sub_f32 v130, v130, v7
    v_sub_f32 v131, v131, v7
    v_mul_f32 v32, v128, v8
    v_fmac_f32 v32, v129, v9
    v_fmac_f32 v32, v130, v10
    v_fmac_f32 v32, v131, v11
    v_fma_f32 v12, v16, v8, -v12
    v_fma_f32 v13, v17, v9, -v13
    v_fma_f32 v14, v18, v10, -v14
    v_fma_f32 v15, v19, v11, -v15
    v_add_f32_dpp v28, v32, v32 row_mirror row_mask:0xf bank_mask:0xc
    v_mov_b32_dpp v7, v3 row_newbcast:13 row_mask:0xf bank_mask:0xf
    v_add_f32_dpp v29, v29, v29 row_mirror row_mask:0xf bank_mask:0x3
    s_waitcnt vmcnt(14)
    s_add_u32 s12, s4, 49152
    buffer_load_dwordx4 v[128:131], v1, s[48:51], s12 offen nt
    v_cvt_f32_i32 v132, v132
    v_cvt_f32_i32 v133, v133
    v_cvt_f32_i32 v134, v134
    v_cvt_f32_i32 v135, v135
    v_sub_f32 v132, v132, v7
    v_sub_f32 v133, v133, v7
    v_sub_f32 v134, v134, v7
    v_sub_f32 v135, v135, v7
    v_mul_f32 v32, v132, v12
    v_fmac_f32 v32, v133, v13
    v_fmac_f32 v32, v134, v14
    v_fmac_f32 v32, v135, v15
    v_fma_f32 v8, v16, v12, -v8
    v_fma_f32 v9, v17, v13, -v9
    v_fma_f32 v10, v18, v14, -v10
    v_fma_f32 v11, v19, v15, -v11
    v_add_f32_dpp v29, v32, v32 row_mirror row_mask:0xf bank_mask:0xc
    v_mov_b32_dpp v7, v3 row_newbcast:14 row_mask:0xf bank_mask:0xf
    v_add_f32_dpp v30, v30, v30 row_mirror row_mask:0xf bank_mask:0x3
    s_waitcnt vmcnt(14)
    s_add_u32 s12, s4, 53248
    buffer_load_dwordx4 v[132:135], v1, s[48:51], s12 offen nt
    v_cvt_f32_i32 v136, v136
    v_cvt_f32_i32 v137, v137
    v_cvt_f32_i32 v138, v138
    v_cvt_f32_i32 v139, v139
    v_sub_f32 v136, v136, v7
    v_sub_f32 v137, v137, v7
    v_sub_f32 v138, v138, v7
    v_sub_f32 v139, v139, v7
    v_mul_f32 v32, v136, v8
    v_fmac_f32 v32, v137, v9
    v_fmac_f32 v32, v138, v10
    v_fmac_f32 v32, v139, v11
    v_fma_f32 v12, v16, v8, -v12
    v_fma_f32 v13, v17, v9, -v13
    v_fma_f32 v14, v18, v10, -v14
    v_fma_f32 v15, v19, v11, -v15
    v_add_f32_dpp v30, v32, v32 row_mirror row_mask:0xf bank_mask:0xc
    v_mov_b32_dpp v7, v3 row_newbcast:15 row_mask:0xf bank_mask:0xf
    v_add_f32_dpp v31, v31, v31 row_mirror row_mask:0xf bank_mask:0x3
    s_waitcnt vmcnt(14)
    s_add_u32 s12, s4, 57344
    buffer_load_dwordx4 v[136:139], v1, s[48:51], s12 offen nt
    v_cvt_f32_i32 v140, v140
    v_cvt_f32_i32 v141, v141
    v_cvt_f32_i32 v142, v142
    v_cvt_f32_i32 v143, v143
    v_sub_f32 v140, v140, v7
    v_sub_f32 v141, v141, v7
    v_sub_f32 v142, v142, v7
    v_sub_f32 v143, v143, v7
    v_mul_f32 v32, v140, v12
    v_fmac_f32 v32, v141, v13
    v_fmac_f32 v32, v142, v14
    v_fmac_f32 v32, v143, v15
    v_fma_f32 v8, v16, v12, -v8
    v_fma_f32 v9, v17, v13, -v9
    v_fma_f32 v10, v18, v14, -v10
    v_fma_f32 v11, v19, v15, -v11
    v_add_f32_dpp v31, v32, v32 row_mirror row_mask:0xf bank_mask:0xc
    s_nop 1
    v_add_f32_dpp v24, v24, v24 row_half_mirror row_mask:0xf bank_mask:0x5
    v_add_f32_dpp v25, v25, v25 row_half_mirror row_mask:0xf bank_mask:0x5
    v_add_f32_dpp v26, v26, v26 row_half_mirror row_mask:0xf bank_mask:0x5
    v_add_f32_dpp v27, v27, v27 row_half_mirror row_mask:0xf bank_mask:0x5
    v_add_f32_dpp v24, v28, v28 row_half_mirror row_mask:0xf bank_mask:0xa
    v_add_f32_dpp v25, v29, v29 row_half_mirror row_mask:0xf bank_mask:0xa
    v_add_f32_dpp v26, v30, v30 row_half_mirror row_mask:0xf bank_mask:0xa
    v_add_f32_dpp v27, v31, v31 row_half_mirror row_mask:0xf bank_mask:0xa
    v_add_f32_dpp v28, v24, v24 quad_perm:[2,3,0,1] row_mask:0xf bank_mask:0xf
    v_add_f32_dpp v29, v25, v25 quad_perm:[2,3,0,1] row_mask:0xf bank_mask:0xf
    v_add_f32_dpp v30, v26, v26 quad_perm:[2,3,0,1] row_mask:0xf bank_mask:0xf
    v_add_f32_dpp v31, v27, v27 quad_perm:[2,3,0,1] row_mask:0xf bank_mask:0xf
    v_cndmask_b32 v24, v28, v30, s[16:17]
    v_cndmask_b32 v25, v29, v31, s[16:17]
    s_waitcnt lgkmcnt(0)
    v_lshlrev_b32 v4, 16, v4
    v_add_f32_dpp v26, v24, v24 quad_perm:[1,0,3,2] row_mask:0xf bank_mask:0xf
    v_add_f32_dpp v27, v25, v25 quad_perm:[1,0,3,2] row_mask:0xf bank_mask:0xf
    v_lshlrev_b32 v5, 16, v5
    v_cndmask_b32 v24, v26, v27, s[18:19]
    v_mul_f32 v24, v24, v4
    v_lshlrev_b32 v6, 16, v6
    v_mov_b32 v25, v24
    s_nop 1
    v_permlane16_swap_b32 v24, v25
    v_add_f32 v24, v24, v25
    v_mul_f32 v24, s22, v24
    s_nop 1
    v_max_f32_dpp v25, v24, v24 row_ror:8 row_mask:0xf bank_mask:0xf
    s_nop 1
    v_max_f32_dpp v25, v25, v25 row_ror:4 row_mask:0xf bank_mask:0xf
    s_nop 1
    v_max_f32_dpp v25, v25, v25 row_ror:2 row_mask:0xf bank_mask:0xf
    s_nop 1
    v_max_f32_dpp v25, v25, v25 row_ror:1 row_mask:0xf bank_mask:0xf
    v_mov_b32 v26, v25
    s_nop 1
    v_permlane32_swap_b32 v25, v26
    v_max3_f32 v27, v25, v26, v40
    v_sub_f32 v28, v24, v27
    v_sub_f32 v31, v40, v27
    v_exp_f32 v28, v28
    v_exp_f32 v31, v31
    v_mov_b32 v40, v27
    v_mul_f32 v29, v28, v5
    v_mul_f32 v30, v29, v6
    v_fma_f32 v41, v41, v31, v28
    v_mov_b32 v56, v41
    s_nop 0
    v_add_f32_dpp v30, v30, v30 row_ror:8 row_mask:0xf bank_mask:0xf
    v_add_f32_dpp v56, v56, v56 row_ror:8 row_mask:0xf bank_mask:0xf
    s_nop 0
    v_add_f32_dpp v30, v30, v30 row_ror:4 row_mask:0xf bank_mask:0xf
    v_add_f32_dpp v56, v56, v56 row_ror:4 row_mask:0xf bank_mask:0xf
    s_nop 0
    v_add_f32_dpp v30, v30, v30 row_ror:2 row_mask:0xf bank_mask:0xf
    v_add_f32_dpp v56, v56, v56 row_ror:2 row_mask:0xf bank_mask:0xf
    s_nop 0
    v_add_f32_dpp v30, v30, v30 row_ror:1 row_mask:0xf bank_mask:0xf
    v_add_f32_dpp v56, v56, v56 row_ror:1 row_mask:0xf bank_mask:0xf
    s_nop 0
    v_mov_b32 v57, v56
    v_fma_f32 v20, v20, v31, -v30
    v_fma_f32 v21, v21, v31, -v30
    v_fma_f32 v22, v22, v31, -v30
    v_fma_f32 v23, v23, v31, -v30
    v_permlane32_swap_b32 v56, v57
    v_add_f32 v56, v56, v57
    v_mov_b32_dpp v7, v29 row_newbcast:0 row_mask:0xf bank_mask:0xf
    s_waitcnt vmcnt(14)
    s_add_u32 s12, s4, 61440
    buffer_load_dwordx4 v[140:143], v1, s[48:51], s12 offen nt
    v_cvt_f32_i32 v80, v80
    v_cvt_f32_i32 v81, v81
    v_cvt_f32_i32 v82, v82
    v_cvt_f32_i32 v83, v83
    v_fmac_f32 v20, v7, v80
    v_fmac_f32 v21, v7, v81
    v_fmac_f32 v22, v7, v82
    v_fmac_f32 v23, v7, v83
    v_mov_b32_dpp v7, v29 row_newbcast:1 row_mask:0xf bank_mask:0xf
    s_waitcnt vmcnt(14)
    buffer_load_dwordx4 v[80:83], v1, s[44:47], s5 offen nt
    v_cvt_f32_i32 v84, v84
    v_cvt_f32_i32 v85, v85
    v_cvt_f32_i32 v86, v86
    v_cvt_f32_i32 v87, v87
    v_fmac_f32 v20, v7, v84
    v_fmac_f32 v21, v7, v85
    v_fmac_f32 v22, v7, v86
    v_fmac_f32 v23, v7, v87
    v_mov_b32_dpp v7, v29 row_newbcast:2 row_mask:0xf bank_mask:0xf
    s_waitcnt vmcnt(14)
    s_add_u32 s12, s5, 4096
    buffer_load_dwordx4 v[84:87], v1, s[44:47], s12 offen nt
    v_cvt_f32_i32 v88, v88
    v_cvt_f32_i32 v89, v89
    v_cvt_f32_i32 v90, v90
    v_cvt_f32_i32 v91, v91
    v_fmac_f32 v20, v7, v88
    v_fmac_f32 v21, v7, v89
    v_fmac_f32 v22, v7, v90
    v_fmac_f32 v23, v7, v91
    v_mov_b32_dpp v7, v29 row_newbcast:3 row_mask:0xf bank_mask:0xf
    s_waitcnt vmcnt(14)
    s_add_u32 s12, s5, 8192
    buffer_load_dwordx4 v[88:91], v1, s[44:47], s12 offen nt
    v_cvt_f32_i32 v92, v92
    v_cvt_f32_i32 v93, v93
    v_cvt_f32_i32 v94, v94
    v_cvt_f32_i32 v95, v95
    v_fmac_f32 v20, v7, v92
    v_fmac_f32 v21, v7, v93
    v_fmac_f32 v22, v7, v94
    v_fmac_f32 v23, v7, v95
    v_mov_b32_dpp v7, v29 row_newbcast:4 row_mask:0xf bank_mask:0xf
    s_waitcnt vmcnt(14)
    s_add_u32 s12, s5, 12288
    buffer_load_dwordx4 v[92:95], v1, s[44:47], s12 offen nt
    v_cvt_f32_i32 v96, v96
    v_cvt_f32_i32 v97, v97
    v_cvt_f32_i32 v98, v98
    v_cvt_f32_i32 v99, v99
    v_fmac_f32 v20, v7, v96
    v_fmac_f32 v21, v7, v97
    v_fmac_f32 v22, v7, v98
    v_fmac_f32 v23, v7, v99
    v_mov_b32_dpp v7, v29 row_newbcast:5 row_mask:0xf bank_mask:0xf
    s_waitcnt vmcnt(14)
    s_add_u32 s12, s5, 16384
    buffer_load_dwordx4 v[96:99], v1, s[44:47], s12 offen nt
    v_cvt_f32_i32 v100, v100
    v_cvt_f32_i32 v101, v101
    v_cvt_f32_i32 v102, v102
    v_cvt_f32_i32 v103, v103
    v_fmac_f32 v20, v7, v100
    v_fmac_f32 v21, v7, v101
    v_fmac_f32 v22, v7, v102
    v_fmac_f32 v23, v7, v103
    v_mov_b32_dpp v7, v29 row_newbcast:6 row_mask:0xf bank_mask:0xf
    s_waitcnt vmcnt(14)
    s_add_u32 s12, s5, 20480
    buffer_load_dwordx4 v[100:103], v1, s[44:47], s12 offen nt
    v_cvt_f32_i32 v104, v104
    v_cvt_f32_i32 v105, v105
    v_cvt_f32_i32 v106, v106
    v_cvt_f32_i32 v107, v107
    v_fmac_f32 v20, v7, v104
    v_fmac_f32 v21, v7, v105
    v_fmac_f32 v22, v7, v106
    v_fmac_f32 v23, v7, v107
    v_mov_b32_dpp v7, v29 row_newbcast:7 row_mask:0xf bank_mask:0xf
    s_waitcnt vmcnt(14)
    s_add_u32 s12, s5, 24576
    buffer_load_dwordx4 v[104:107], v1, s[44:47], s12 offen nt
    v_cvt_f32_i32 v108, v108
    v_cvt_f32_i32 v109, v109
    v_cvt_f32_i32 v110, v110
    v_cvt_f32_i32 v111, v111
    v_fmac_f32 v20, v7, v108
    v_fmac_f32 v21, v7, v109
    v_fmac_f32 v22, v7, v110
    v_fmac_f32 v23, v7, v111
    v_mov_b32_dpp v7, v29 row_newbcast:8 row_mask:0xf bank_mask:0xf
    s_waitcnt vmcnt(14)
    s_add_u32 s12, s5, 28672
    buffer_load_dwordx4 v[108:111], v1, s[44:47], s12 offen nt
    v_cvt_f32_i32 v112, v112
    v_cvt_f32_i32 v113, v113
    v_cvt_f32_i32 v114, v114
    v_cvt_f32_i32 v115, v115
    v_fmac_f32 v20, v7, v112
    v_fmac_f32 v21, v7, v113
    v_fmac_f32 v22, v7, v114
    v_fmac_f32 v23, v7, v115
    v_mov_b32_dpp v7, v29 row_newbcast:9 row_mask:0xf bank_mask:0xf
    s_waitcnt vmcnt(14)
    s_add_u32 s12, s5, 32768
    buffer_load_dwordx4 v[112:115], v1, s[44:47], s12 offen nt
    v_cvt_f32_i32 v116, v116
    v_cvt_f32_i32 v117, v117
    v_cvt_f32_i32 v118, v118
    v_cvt_f32_i32 v119, v119
    v_fmac_f32 v20, v7, v116
    v_fmac_f32 v21, v7, v117
    v_fmac_f32 v22, v7, v118
    v_fmac_f32 v23, v7, v119
    v_mov_b32_dpp v7, v29 row_newbcast:10 row_mask:0xf bank_mask:0xf
    s_waitcnt vmcnt(14)
    s_add_u32 s12, s5, 36864
    buffer_load_dwordx4 v[116:119], v1, s[44:47], s12 offen nt
    v_cvt_f32_i32 v120, v120
    v_cvt_f32_i32 v121, v121
    v_cvt_f32_i32 v122, v122
    v_cvt_f32_i32 v123, v123
    v_fmac_f32 v20, v7, v120
    v_fmac_f32 v21, v7, v121
    v_fmac_f32 v22, v7, v122
    v_fmac_f32 v23, v7, v123
    v_mov_b32_dpp v7, v29 row_newbcast:11 row_mask:0xf bank_mask:0xf
    s_waitcnt vmcnt(14)
    s_add_u32 s12, s5, 40960
    buffer_load_dwordx4 v[120:123], v1, s[44:47], s12 offen nt
    v_cvt_f32_i32 v124, v124
    v_cvt_f32_i32 v125, v125
    v_cvt_f32_i32 v126, v126
    v_cvt_f32_i32 v127, v127
    v_fmac_f32 v20, v7, v124
    v_fmac_f32 v21, v7, v125
    v_fmac_f32 v22, v7, v126
    v_fmac_f32 v23, v7, v127
    v_mov_b32_dpp v7, v29 row_newbcast:12 row_mask:0xf bank_mask:0xf
    s_waitcnt vmcnt(14)
    s_add_u32 s12, s5, 45056
    buffer_load_dwordx4 v[124:127], v1, s[44:47], s12 offen nt
    v_cvt_f32_i32 v128, v128
    v_cvt_f32_i32 v129, v129
    v_cvt_f32_i32 v130, v130
    v_cvt_f32_i32 v131, v131
    v_fmac_f32 v20, v7, v128
    v_fmac_f32 v21, v7, v129
    v_fmac_f32 v22, v7, v130
    v_fmac_f32 v23, v7, v131
    v_mov_b32_dpp v7, v29 row_newbcast:13 row_mask:0xf bank_mask:0xf
    s_waitcnt vmcnt(14)
    s_add_u32 s12, s5, 49152
    buffer_load_dwordx4 v[128:131], v1, s[44:47], s12 offen nt
    v_cvt_f32_i32 v132, v132
    v_cvt_f32_i32 v133, v133
    v_cvt_f32_i32 v134, v134
    v_cvt_f32_i32 v135, v135
    v_fmac_f32 v20, v7, v132
    v_fmac_f32 v21, v7, v133
    v_fmac_f32 v22, v7, v134
    v_fmac_f32 v23, v7, v135
    v_mov_b32_dpp v7, v29 row_newbcast:14 row_mask:0xf bank_mask:0xf
    s_waitcnt vmcnt(14)
    s_add_u32 s12, s5, 53248
    buffer_load_dwordx4 v[132:135], v1, s[44:47], s12 offen nt
    v_cvt_f32_i32 v136, v136
    v_cvt_f32_i32 v137, v137
    v_cvt_f32_i32 v138, v138
    v_cvt_f32_i32 v139, v139
    v_fmac_f32 v20, v7, v136
    v_fmac_f32 v21, v7, v137
    v_fmac_f32 v22, v7, v138
    v_fmac_f32 v23, v7, v139
    v_mov_b32_dpp v7, v29 row_newbcast:15 row_mask:0xf bank_mask:0xf
    s_waitcnt vmcnt(14)
    s_add_u32 s12, s5, 57344
    buffer_load_dwordx4 v[136:139], v1, s[44:47], s12 offen nt
    v_cvt_f32_i32 v140, v140
    v_cvt_f32_i32 v141, v141
    v_cvt_f32_i32 v142, v142
    v_cvt_f32_i32 v143, v143
    v_fmac_f32 v20, v7, v140
    v_fmac_f32 v21, v7, v141
    v_fmac_f32 v22, v7, v142
    v_fmac_f32 v23, v7, v143
    s_mov_b32 s4, s5
    s_add_u32 s6, s6, 1
    s_cmp_lt_u32 s6, 4
    s_cbranch_scc1 L_chunke
    v_mov_b32 v39, v40
    v_mov_b32 v38, v56
    v_permlane32_swap_b32 v20, v22
    v_permlane32_swap_b32 v21, v23
    s_lshl_b32 s12, s3, 10
    v_add_u32 v33, s12, v1
    v_add_f32 v36, v20, v22
    v_add_f32 v37, v21, v23
    ds_write_b128 v33, v[36:39] offset:10240
    s_waitcnt lgkmcnt(0)
    s_cmp_lg_u32 s3, 0
    s_cbranch_scc1 L_others
    v_and_b32 v33, 15, v0
    v_lshlrev_b32 v33, 7, v33
    s_lshl_b32 s96, s11, 15
    s_lshr_b32 s12, s11, 3
    s_xor_b32 s12, s12, 0
    s_lshl_b32 s12, s12, 13
    s_add_u32 s96, s96, s12
    s_and_b32 s12, s15, 15
    s_lshl_b32 s97, s12, 9
    s_add_u32 s97, s97, s96
    s_lshl_b32 s98, s12, 7
    s_add_u32 s98, s98, s96
    s_add_u32 s98, s98, 16384
    v_lshlrev_b32 v34, 3, v0
    v_and_b32 v35, 31, v0
    v_lshlrev_b32 v35, 3, v35
    v_lshrrev_b32 v7, 5, v0
    v_lshl_add_u32 v35, v7, 2, v35
    s_barrier
    ds_read_b128 v[44:47], v1 offset:10240
    ds_read_b128 v[48:51], v1 offset:11264
    ds_read_b128 v[52:55], v1 offset:12288
    ds_read_b128 v[56:59], v1 offset:13312
    s_waitcnt lgkmcnt(1)
    v_max3_f32 v39, v47, v51, v55
    s_waitcnt lgkmcnt(0)
    v_max_f32 v39, v39, v59
    v_sub_f32 v47, v47, v39
    v_sub_f32 v51, v51, v39
    v_sub_f32 v55, v55, v39
    v_sub_f32 v59, v59, v39
    v_exp_f32 v47, v47
    v_exp_f32 v51, v51
    v_exp_f32 v55, v55
    v_exp_f32 v59, v59
    s_nop 0
    v_mul_f32 v36, v44, v47
    v_mul_f32 v37, v45, v47
    v_mul_f32 v38, v46, v47
    v_fmac_f32 v36, v48, v51
    v_fmac_f32 v37, v49, v51
    v_fmac_f32 v38, v50, v51
    v_fmac_f32 v36, v52, v55
    v_fmac_f32 v37, v53, v55
    v_fmac_f32 v38, v54, v55
    v_fmac_f32 v36, v56, v59
    v_fmac_f32 v37, v57, v59
    v_fmac_f32 v38, v58, v59
    buffer_store_dwordx2 v[36:37], v34, s[84:87], s97 offen sc1
    s_mov_b64 exec, 0xffff
    buffer_store_dwordx2 v[38:39], v34, s[84:87], s98 offen sc1
    s_mov_b64 exec, 1
    s_waitcnt vmcnt(0)
    v_mov_b32 v7, 1
    s_lshl_b32 s12, s11, 4
    buffer_atomic_add v7, off, s[88:91], s12 sc0 sc1
    s_mov_b64 exec, -1
    s_lshl_b32 s15, s11, 14
    s_waitcnt vmcnt(0)
    v_readfirstlane_b32 s14, v7
    s_nop 3
    s_cmp_lg_u32 s14, 15
    s_cbranch_scc1 L_end
    s_add_u32 s12, s96, 16384
    buffer_load_dwordx2 v[24:25], v33, s[84:87], s12 offen sc1
    s_add_u32 s12, s96, 4096
    buffer_load_dwordx2 v[80:81], v34, s[84:87], s96 offen offset:0 sc1
    buffer_load_dwordx2 v[82:83], v34, s[84:87], s96 offen offset:512 sc1
    buffer_load_dwordx2 v[84:85], v34, s[84:87], s96 offen offset:1024 sc1
    buffer_load_dwordx2 v[86:87], v34, s[84:87], s96 offen offset:1536 sc1
    buffer_load_dwordx2 v[88:89], v34, s[84:87], s96 offen offset:2048 sc1
    buffer_load_dwordx2 v[90:91], v34, s[84:87], s96 offen offset:2560 sc1
    buffer_load_dwordx2 v[92:93], v34, s[84:87], s96 offen offset:3072 sc1
    buffer_load_dwordx2 v[94:95], v34, s[84:87], s96 offen offset:3584 sc1
    buffer_load_dwordx2 v[96:97], v34, s[84:87], s12 offen offset:0 sc1
    buffer_load_dwordx2 v[98:99], v34, s[84:87], s12 offen offset:512 sc1
    buffer_load_dwordx2 v[100:101], v34, s[84:87], s12 offen offset:1024 sc1
    buffer_load_dwordx2 v[102:103], v34, s[84:87], s12 offen offset:1536 sc1
    buffer_load_dwordx2 v[104:105], v34, s[84:87], s12 offen offset:2048 sc1
    buffer_load_dwordx2 v[106:107], v34, s[84:87], s12 offen offset:2560 sc1
    buffer_load_dwordx2 v[108:109], v34, s[84:87], s12 offen offset:3072 sc1
    buffer_load_dwordx2 v[110:111], v34, s[84:87], s12 offen offset:3584 sc1
    s_waitcnt vmcnt(16)
    v_max_f32_dpp v39, v25, v25 row_ror:8 row_mask:0xf bank_mask:0xf
    s_nop 1
    v_max_f32_dpp v39, v39, v39 row_ror:4 row_mask:0xf bank_mask:0xf
    s_nop 1
    v_max_f32_dpp v39, v39, v39 row_ror:2 row_mask:0xf bank_mask:0xf
    s_nop 1
    v_max_f32_dpp v39, v39, v39 row_ror:1 row_mask:0xf bank_mask:0xf
    v_sub_f32 v26, v25, v39
    v_exp_f32 v26, v26
    s_nop 0
    v_mul_f32 v38, v24, v26
    v_mov_b32 v36, 0
    v_mov_b32 v37, 0
    s_waitcnt vmcnt(15)
    v_fmac_f32_dpp v36, v26, v80 row_newbcast:0 row_mask:0xf bank_mask:0xf
    v_fmac_f32_dpp v37, v26, v81 row_newbcast:0 row_mask:0xf bank_mask:0xf
    v_add_f32_dpp v38, v38, v38 row_ror:8 row_mask:0xf bank_mask:0xf
    s_waitcnt vmcnt(14)
    v_fmac_f32_dpp v36, v26, v82 row_newbcast:1 row_mask:0xf bank_mask:0xf
    v_fmac_f32_dpp v37, v26, v83 row_newbcast:1 row_mask:0xf bank_mask:0xf
    s_waitcnt vmcnt(13)
    v_fmac_f32_dpp v36, v26, v84 row_newbcast:2 row_mask:0xf bank_mask:0xf
    v_fmac_f32_dpp v37, v26, v85 row_newbcast:2 row_mask:0xf bank_mask:0xf
    v_add_f32_dpp v38, v38, v38 row_ror:4 row_mask:0xf bank_mask:0xf
    s_waitcnt vmcnt(12)
    v_fmac_f32_dpp v36, v26, v86 row_newbcast:3 row_mask:0xf bank_mask:0xf
    v_fmac_f32_dpp v37, v26, v87 row_newbcast:3 row_mask:0xf bank_mask:0xf
    s_waitcnt vmcnt(11)
    v_fmac_f32_dpp v36, v26, v88 row_newbcast:4 row_mask:0xf bank_mask:0xf
    v_fmac_f32_dpp v37, v26, v89 row_newbcast:4 row_mask:0xf bank_mask:0xf
    v_add_f32_dpp v38, v38, v38 row_ror:2 row_mask:0xf bank_mask:0xf
    s_waitcnt vmcnt(10)
    v_fmac_f32_dpp v36, v26, v90 row_newbcast:5 row_mask:0xf bank_mask:0xf
    v_fmac_f32_dpp v37, v26, v91 row_newbcast:5 row_mask:0xf bank_mask:0xf
    s_waitcnt vmcnt(9)
    v_fmac_f32_dpp v36, v26, v92 row_newbcast:6 row_mask:0xf bank_mask:0xf
    v_fmac_f32_dpp v37, v26, v93 row_newbcast:6 row_mask:0xf bank_mask:0xf
    v_add_f32_dpp v38, v38, v38 row_ror:1 row_mask:0xf bank_mask:0xf
    s_waitcnt vmcnt(8)
    v_fmac_f32_dpp v36, v26, v94 row_newbcast:7 row_mask:0xf bank_mask:0xf
    v_fmac_f32_dpp v37, v26, v95 row_newbcast:7 row_mask:0xf bank_mask:0xf
    s_waitcnt vmcnt(7)
    v_fmac_f32_dpp v36, v26, v96 row_newbcast:8 row_mask:0xf bank_mask:0xf
    v_fmac_f32_dpp v37, v26, v97 row_newbcast:8 row_mask:0xf bank_mask:0xf
    s_waitcnt vmcnt(6)
    v_fmac_f32_dpp v36, v26, v98 row_newbcast:9 row_mask:0xf bank_mask:0xf
    v_fmac_f32_dpp v37, v26, v99 row_newbcast:9 row_mask:0xf bank_mask:0xf
    s_waitcnt vmcnt(5)
    v_fmac_f32_dpp v36, v26, v100 row_newbcast:10 row_mask:0xf bank_mask:0xf
    v_fmac_f32_dpp v37, v26, v101 row_newbcast:10 row_mask:0xf bank_mask:0xf
    s_waitcnt vmcnt(4)
    v_fmac_f32_dpp v36, v26, v102 row_newbcast:11 row_mask:0xf bank_mask:0xf
    v_fmac_f32_dpp v37, v26, v103 row_newbcast:11 row_mask:0xf bank_mask:0xf
    s_waitcnt vmcnt(3)
    v_fmac_f32_dpp v36, v26, v104 row_newbcast:12 row_mask:0xf bank_mask:0xf
    v_fmac_f32_dpp v37, v26, v105 row_newbcast:12 row_mask:0xf bank_mask:0xf
    s_waitcnt vmcnt(2)
    v_fmac_f32_dpp v36, v26, v106 row_newbcast:13 row_mask:0xf bank_mask:0xf
    v_fmac_f32_dpp v37, v26, v107 row_newbcast:13 row_mask:0xf bank_mask:0xf
    s_waitcnt vmcnt(1)
    v_fmac_f32_dpp v36, v26, v108 row_newbcast:14 row_mask:0xf bank_mask:0xf
    v_fmac_f32_dpp v37, v26, v109 row_newbcast:14 row_mask:0xf bank_mask:0xf
    s_waitcnt vmcnt(0)
    v_fmac_f32_dpp v36, v26, v110 row_newbcast:15 row_mask:0xf bank_mask:0xf
    v_fmac_f32_dpp v37, v26, v111 row_newbcast:15 row_mask:0xf bank_mask:0xf
    v_rcp_f32 v38, v38
    s_nop 0
    v_mul_f32 v36, v36, v38
    v_mul_f32 v37, v37, v38
    v_cvt_pk_bf16_f32 v36, v36, v37
    buffer_store_dword v36, v35, s[80:83], s10 offen
    s_endpgm
L_others:
    s_barrier
L_end:
    s_endpgm
.p2align 6
.type rope_consts,@object
rope_consts:
    .long 0x3e230000, 0x3e0d2000, 0x3df46000, 0x3dd3a000, 0x3db74000, 0x3d9ec000, 0x3d898000, 0x3d6e0000
    .long 0x3d4e2000, 0x3d328000, 0x3d1aa000, 0x3d05e000, 0x3ce7e000, 0x3cc8c000, 0x3cade000, 0x3c968000
    .long 0x3c826000, 0x3c61c000, 0x3c438000, 0x3c296000, 0x3c12a000, 0x3bfe0000, 0x3bdbe000, 0x3bbe8000
    .long 0x3ba4e000, 0x3b8ee000, 0x3b776000, 0x3b564000, 0x3b398000, 0x3b20a000, 0x3b0b2000, 0x3af0e000
    .long 0x3ad0a000, 0x3ab4a000, 0x3a9c6000, 0x3a878000, 0x3a6aa000, 0x3a4b2000, 0x3a300000, 0x3a186000
    .long 0x3a03e000, 0x39e48000, 0x39c5e000, 0x39ab6000, 0x39946000, 0x39808000, 0x395e8000, 0x3940c000
    .long 0x3926e000, 0x39108000, 0x38fa4000, 0x38d8c000, 0x38bbc000, 0x38a28000, 0x388cc000, 0x3873c000
    .long 0x38532000, 0x3836c000, 0x381e4000, 0x38092000, 0x37ed6000, 0x37cda000, 0x37b20000, 0x379a2000
    .long 0xb7cf9236, 0x36abf350, 0x37d71257, 0x37a5e905, 0x37b767f0, 0xb73e8f8b, 0xb7c5dd23, 0x37678cb9
    .long 0x36c01d23, 0x368d051c, 0xb7114d8c, 0xb5c40d89, 0xb63fce6b, 0x364e78d9, 0xb5b17f03, 0x36f672e7
    .long 0x351b0938, 0x366f205d, 0x362c0273, 0xb62e74b5, 0x35311bb5, 0xb59876e9, 0x35c35ec2, 0xb5e06c85
    .long 0x35b34b14, 0xb5fad6fb, 0xb50219c0, 0xb573f67c, 0xb49969c9, 0xb39e8d97, 0xb509e221, 0x342e240c
    .long 0xb40ed969, 0x3431d588, 0x34f01241, 0xb48b8e88, 0xb2fbf1c2, 0x34393a79, 0xb47d51de, 0xb39a2ec9
    .long 0x3475d5aa, 0x3184ddaf, 0xb04cea2b, 0xb3399286, 0x32a4238a, 0xb1fdaf58, 0x333cf472, 0xb3071ca2
    .long 0x32353b70, 0x328e4c93, 0x32b3401c, 0xb113ed2f, 0xb2e606ba, 0x329426a1, 0x2f89bc62, 0x31a2bf9a
    .long 0xb1ed5447, 0x32536956, 0x324b86f9, 0xb230a928, 0x31a80a24, 0xb17f99c4, 0x3197321b, 0x31c71012
    .long 0xbe94fdf6, 0x3fcca455, 0x3ff5be33, 0x3f6da3d6, 0xbed92015, 0xbfba9645, 0xbff92480, 0xbff9d190
    .long 0xbfd191e5, 0xbf94bb7e, 0xbf241e33, 0xbe136082, 0x3e972ca3, 0x3f2a3151, 0x3f77407a, 0x3f9a4f45
    .long 0x3fb25b5f, 0x3fc4fc92, 0x3fd34c54, 0x3fde3980, 0x3fe68752, 0x3fecd173, 0x3ff191ea, 0x3ff5273c
    .long 0x3ff7da02, 0x3ff9e1a3, 0x3ffb6838, 0x3ffc8da0, 0x3ffd69f1, 0x3ffe0f51, 0x3ffe8b6c, 0x3ffee88a
    .long 0x3fff2e66, 0x3fff62cc, 0x3fff8a1b, 0x3fffa795, 0x3fffbdb2, 0x3fffce46, 0x3fffdab6, 0x3fffe409
    .long 0x3fffeb08, 0x3ffff046, 0x3ffff435, 0x3ffff728, 0x3ffff95e, 0x3ffffb07, 0x3ffffc45, 0x3ffffd34
    .long 0x3ffffde7, 0x3ffffe6d, 0x3ffffed2, 0x3fffff1e, 0x3fffff56, 0x3fffff81, 0x3fffffa1, 0x3fffffb8
    .long 0x3fffffca, 0x3fffffd8, 0x3fffffe2, 0x3fffffe9, 0x3fffffef, 0x3ffffff3, 0x3ffffff6, 0x3ffffff9
    .long 0x3f7d4695, 0x3f19cf7f, 0xbe8f7a0e, 0xbf62c145, 0xbf7a2dd4, 0xbf2f4661, 0xbe6b6c10, 0x3e5faa9f
    .long 0x3f13067d, 0x3f505ca4, 0x3f727ded, 0x3f7f5618, 0x3f7d31e3, 0x3f71715a, 0x3f602bc6, 0x3f4c440e
    .long 0x3f37a4a6, 0x3f238005, 0x3f1087d4, 0x3efe2ecc, 0x3edea4d1, 0x3ec27469, 0x3ea97819, 0x3e9374f0
    .long 0x3e802652, 0x3e5e8a8e, 0x3e41198b, 0x3e277817, 0x3e112f8e, 0x3dfba9f2, 0x3dda11ea, 0x3dbcee33
    .long 0x3da3aa50, 0x3d8dc421, 0x3d7593f6, 0x3d54b195, 0x3d3834b3, 0x3d1f8777, 0x3d0a27c1, 0x3cef4957
    .long 0x3ccf388f, 0x3cb37362, 0x3c9b66aa, 0x3c8692e2, 0x3c691325, 0x3c49d60d, 0x3c2ec8b5, 0x3c175b81
    .long 0x3c031213, 0x3be3016b, 0x3bc4943f, 0x3baa3b12, 0x3b9369f5, 0x3b7f4f82, 0x3b5d170a, 0x3b3f74c5
    .long 0x3b25cb54, 0x3b0f926a, 0x3af8a80b, 0x3ad753de, 0x3aba774f, 0x3aa17913, 0x3a8bd470, 0x3a722ce0
.size rope_consts, 1024
.section .rodata,"a"
.p2align 6
.amdhsa_kernel standalone__kv_cache_quant_pre_rope_vs_post_rope__decode_kernel
  .amdhsa_next_free_vgpr 144
  .amdhsa_next_free_sgpr 102
  .amdhsa_accum_offset 144
  .amdhsa_group_segment_fixed_size 0
  .amdhsa_kernarg_size 112
  .amdhsa_user_sgpr_count 2
  .amdhsa_user_sgpr_kernarg_segment_ptr 1
  .amdhsa_system_sgpr_workgroup_id_x 1
.end_amdhsa_kernel
```
